```python
import torch

def _softmax(x, axis=-1):
    return torch.softmax(x, dim=axis)
def _gelu(x):
    return torch.nn.functional.gelu(x, approximate="tanh")
def _silu(x):
    return torch.nn.functional.silu(x)
def _sigmoid(x):
    return torch.sigmoid(x)
def _layernorm(x, axis=-1, eps=1e-5):
    m = x.mean(dim=axis, keepdim=True)
    v = x.var(dim=axis, keepdim=True, unbiased=False)
    return (x - m) / torch.sqrt(v + eps)
def _scatter_add(tgt, idx, src, axis=0):
    return tgt.clone().index_add_(axis, idx, src)
def _segment_sum(src, seg, n):
    out = torch.zeros((n,) + src.shape[1:], dtype=src.dtype)
    return out.index_add_(0, seg, src)
def _pad(x, pw):
    flat = tuple(v for pair in reversed(pw) for v in pair)
    return torch.nn.functional.pad(x, flat)

kernel_name = 'standalone__gqa_softmax__sampling'

def setup_inputs():

    _w = (lambda a: (lambda t: t.to(torch.bfloat16) if t.is_floating_point() else t)(torch.as_tensor(a)))
    B, Hq, Hkv, Sq, Sk, D = 16, 32, 8, 1, 4096, 128
    return {
        "q": _w((lambda *s: torch.randn(*s, dtype=torch.bfloat16) * 0.8)(B, Hq, Sq, D)),
        "k": _w((lambda *s: torch.randn(*s, dtype=torch.bfloat16) * 0.8)(B, Hkv, Sk, D)),
        "v": _w((lambda *s: torch.randn(*s, dtype=torch.bfloat16) * 0.05)(B, Hkv, Sk, D)),
    }

def reference(q, k, v):
    B, Hq, Sq, D = q.shape
    Hkv = k.shape[1]
    rep = Hq // Hkv
    k = (lambda x, n, axis: torch.repeat_interleave(x, n, dim=axis))(k, rep, axis=1)
    v = (lambda x, n, axis: torch.repeat_interleave(x, n, dim=axis))(v, rep, axis=1)
    scale = D ** -0.5
    scores = torch.einsum("bhqd,bhkd->bhqk", q, k) * scale
    p = _softmax(scores, axis=-1)
    return torch.einsum("bhqk,bhkd->bhqd", p, v)
```

```asm
; @launch grid=(256,1,1) block=(320,1,1) lds=51264
.amdgcn_target "amdgcn-amd-amdhsa--gfx950"
.text
.globl standalone__gqa_softmax__sampling_kernel
.p2align 8
.type standalone__gqa_softmax__sampling_kernel,@function
standalone__gqa_softmax__sampling_kernel:
    s_load_dwordx2 s[8:9], s[0:1], 8
    s_load_dwordx2 s[12:13], s[0:1], 16
    s_load_dwordx2 s[4:5], s[0:1], 0
    v_lshrrev_b32 v10, 6, v0
    v_and_b32 v0, 63, v0
    s_cmp_ge_u32 s2, 256
    v_readfirstlane_b32 s20, v10
    s_cbranch_scc1 L_end
    s_lshr_b32 s31, s2, 1
    s_and_b32 s30, s2, 1
    s_cmp_eq_u32 s20, 4
    s_cbranch_scc1 L_helper
    v_lshrrev_b32 v10, 4, v0
    v_lshlrev_b32 v1, 9, v10
    v_bfe_u32 v11, v0, 3, 1
    v_lshl_or_b32 v1, v11, 11, v1
    v_bfe_u32 v11, v0, 2, 1
    v_lshl_or_b32 v1, v11, 8, v1
    v_bfe_i32 v11, v0, 5, 1
    v_xor_b32 v11, v11, v0
    v_and_b32 v11, 3, v11
    v_lshl_or_b32 v1, v11, 4, v1
    s_lshl_b32 s56, s20, 12
    s_add_u32 s56, s56, 34880
    s_mov_b32 s10, 0x8000000
    s_mov_b32 s11, 0x20000
    s_lshl_b32 s21, s31, 20
    s_lshl_b32 s22, s30, 19
    s_add_u32 s21, s21, s22
    s_lshl_b32 s22, s20, 12
    s_add_u32 s21, s21, s22
    v_lshrrev_b32 v11, 3, v0
    v_lshlrev_b32 v3, 8, v11
    v_and_b32 v11, 7, v0
    v_lshl_or_b32 v3, v11, 4, v3
    s_lshl_b32 s22, s30, 7
    v_or_b32 v3, s22, v3
    v_xor_b32 v2, 0x80, v3
    s_mov_b32 s14, 0x8000000
    s_mov_b32 s15, 0x20000
    v_bfe_u32 v11, v0, 1, 2
    v_lshlrev_b32 v12, 4, v10
    v_lshl_or_b32 v12, v11, 8, v12
    s_lshl_b32 s22, s31, 10
    s_mov_b32 s6, 0x20000
    s_mov_b32 s7, 0x20000
    s_mov_b32 s18, 0x8000000
    s_mov_b32 s19, 0x20000
    s_add_u32 s23, s21, 49152
    s_mov_b32 s53, s21
    s_waitcnt lgkmcnt(0)
    buffer_load_dwordx4 v[76:79], v1, s[8:11], s21 offen offset:0 nt
    buffer_load_dwordx4 v[80:83], v1, s[8:11], s21 offen offset:64 nt
    buffer_load_dwordx4 v[84:87], v1, s[8:11], s21 offen offset:128 nt
    buffer_load_dwordx4 v[88:91], v1, s[8:11], s21 offen offset:192 nt
    s_add_u32 s21, s21, 16384
    s_mov_b32 s16, s12
    s_mov_b32 s17, s13
    buffer_load_dwordx4 v[28:31], v12, s[4:7], s22 offen offset:0
    buffer_load_dwordx4 v[32:35], v12, s[4:7], s22 offen offset:64
    buffer_load_dwordx4 v[36:39], v12, s[4:7], s22 offen offset:128
    buffer_load_dwordx4 v[40:43], v12, s[4:7], s22 offen offset:192
    buffer_load_dwordx4 v[92:95], v2, s[12:15], s53 offen offset:0 nt
    buffer_load_dwordx4 v[96:99], v3, s[12:15], s53 offen offset:0 nt
    buffer_load_dwordx4 v[100:103], v2, s[12:15], s53 offen offset:2048 nt
    buffer_load_dwordx4 v[104:107], v3, s[12:15], s53 offen offset:2048 nt
    s_add_u32 s53, s53, 16384
    buffer_load_dwordx4 v[108:111], v1, s[8:11], s21 offen offset:0 nt
    buffer_load_dwordx4 v[112:115], v1, s[8:11], s21 offen offset:64 nt
    buffer_load_dwordx4 v[116:119], v1, s[8:11], s21 offen offset:128 nt
    buffer_load_dwordx4 v[120:123], v1, s[8:11], s21 offen offset:192 nt
    s_add_u32 s21, s21, 16384
    s_mov_b32 s25, 0x3fb8aa3b
    s_mov_b32 s55, 0x3db504f3
    s_mov_b32 s26, 0xff00ff00
    s_mov_b32 s27, 0xff00ff00
    s_mov_b32 s28, 0x00ff00ff
    s_mov_b32 s29, 0xff00ff00
    v_and_b32 v11, 1, v0
    v_lshlrev_b32 v11, 4, v11
    v_mov_b32 v12, 0xffff
    v_lshlrev_b32 v5, v11, v12
    s_mul_i32 s52, s20, 4096
    s_add_u32 s52, s52, 18496
    v_lshlrev_b32 v4, 3, v0
    v_add_u32 v4, s52, v4
    v_bfe_i32 v204, v0, 3, 1
    v_xor_b32 v204, v204, v10
    v_and_b32 v204, 3, v204
    v_lshlrev_b32 v204, 4, v204
    v_and_b32 v11, 15, v0
    v_lshl_or_b32 v204, v11, 6, v204
    v_add_u32 v204, s56, v204
    v_lshlrev_b32 v205, 4, v0
    v_add_u32 v205, s56, v205
    v_mov_b32 v6, 0xff800000
    v_mov_b32 v7, 0
    v_mov_b32 v21, 0
    v_mov_b32 v22, 0
    v_mov_b32 v25, 0
    v_mov_b32 v26, 0
    v_mov_b32 v44, 0
    v_mov_b32 v45, 0
    v_mov_b32 v46, 0
    v_mov_b32 v47, 0
    v_mov_b32 v48, 0
    v_mov_b32 v49, 0
    v_mov_b32 v50, 0
    v_mov_b32 v51, 0
    v_mov_b32 v52, 0
    v_mov_b32 v53, 0
    v_mov_b32 v54, 0
    v_mov_b32 v55, 0
    v_mov_b32 v56, 0
    v_mov_b32 v57, 0
    v_mov_b32 v58, 0
    v_mov_b32 v59, 0
    v_mov_b32 v60, 0
    v_mov_b32 v61, 0
    v_mov_b32 v62, 0
    v_mov_b32 v63, 0
    v_mov_b32 v64, 0
    v_mov_b32 v65, 0
    v_mov_b32 v66, 0
    v_mov_b32 v67, 0
    v_mov_b32 v68, 0
    v_mov_b32 v69, 0
    v_mov_b32 v70, 0
    v_mov_b32 v71, 0
    v_mov_b32 v72, 0
    v_mov_b32 v73, 0
    v_mov_b32 v74, 0
    v_mov_b32 v75, 0
    s_mov_b32 s24, 0
    s_waitcnt vmcnt(8)
L_loop:
    s_add_u32 s22, s24, 0
    s_and_b32 s54, s22, 1
    s_cmp_lg_u32 s54, 1
    s_cselect_b32 s18, 0x8000000, 0
    s_and_b32 s54, s24, 1
    s_cmp_eq_u32 s54, 1
    s_cselect_b32 s30, 512, 0
    s_waitcnt vmcnt(8)
    buffer_load_dwordx4 v[124:127], v2, s[12:15], s53 offen offset:0 nt
    buffer_load_dwordx4 v[128:131], v3, s[16:19], s53 offen offset:0 nt
    buffer_load_dwordx4 v[132:135], v2, s[12:15], s53 offen offset:2048 nt
    buffer_load_dwordx4 v[136:139], v3, s[16:19], s53 offen offset:2048 nt
    s_add_u32 s53, s53, 16384
    ds_write_b128 v205, v[76:79] offset:0
    ds_write_b128 v205, v[80:83] offset:1024
    ds_write_b128 v205, v[84:87] offset:2048
    ds_write_b128 v205, v[88:91] offset:3072
    ds_read_b128 v[76:79], v204 offset:0
    ds_read_b128 v[80:83], v204 offset:1024
    ds_read_b128 v[84:87], v204 offset:2048
    ds_read_b128 v[88:91], v204 offset:3072
    s_waitcnt lgkmcnt(3)
    v_mfma_f32_16x16x32_bf16 v[16:19], v[76:79], v[28:31], 0
    s_waitcnt lgkmcnt(2)
    v_mfma_f32_16x16x32_bf16 v[16:19], v[80:83], v[32:35], v[16:19]
    s_waitcnt lgkmcnt(1)
    v_mfma_f32_16x16x32_bf16 v[16:19], v[84:87], v[36:39], v[16:19]
    s_waitcnt lgkmcnt(0)
    v_mfma_f32_16x16x32_bf16 v[16:19], v[88:91], v[40:43], v[16:19]
    s_nop 7
    v_cndmask_b32 v12, v16, v17, s[26:27]
    v_cndmask_b32 v13, v18, v19, s[26:27]
    v_cvt_pk_bf16_f32 v9, v12, v13
    v_lshlrev_b32 v12, 16, v9
    v_and_b32 v13, 0xffff0000, v9
    v_mul_f32 v12, s55, v12
    v_mul_f32 v13, s55, v13
    v_cvt_pk_bf16_f32 v9, v12, v13
    v_lshlrev_b32 v12, 16, v9
    v_and_b32 v13, 0xffff0000, v9
    v_max_f32 v10, v12, v13
    s_nop 1
    v_max_f32_dpp v10, v10, v10 row_ror:8 row_mask:0xf bank_mask:0xf
    v_mov_b32 v9, v10
    s_nop 1
    v_permlane16_swap_b32 v10, v9
    v_max_f32 v10, v10, v9
    v_mov_b32 v9, v10
    s_nop 1
    v_permlane32_swap_b32 v10, v9
    v_max_f32 v10, v10, v9
    v_mul_f32 v10, s25, v10
    v_max_f32 v10, v6, v10
    v_sub_f32 v8, v6, v10
    v_fma_f32 v14, v12, s25, -v10
    v_fma_f32 v15, v13, s25, -v10
    v_exp_f32 v8, v8
    v_exp_f32 v14, v14
    v_exp_f32 v15, v15
    v_mov_b32 v6, v10
    v_fma_f32 v7, v7, v8, v14
    v_cvt_pk_bf16_f32 v9, v14, v14
    v_cvt_pk_bf16_f32 v11, v15, v15
    v_add_f32 v7, v7, v15
    v_and_b32 v20, v9, v5
    v_and_b32 v23, v9, v5
    v_and_b32 v24, v11, v5
    v_and_b32 v27, v11, v5
    v_pk_mul_f32 v[44:45], v[44:45], v[8:9] op_sel_hi:[1,0]
    v_pk_mul_f32 v[46:47], v[46:47], v[8:9] op_sel_hi:[1,0]
    v_pk_mul_f32 v[48:49], v[48:49], v[8:9] op_sel_hi:[1,0]
    v_pk_mul_f32 v[50:51], v[50:51], v[8:9] op_sel_hi:[1,0]
    v_pk_mul_f32 v[52:53], v[52:53], v[8:9] op_sel_hi:[1,0]
    v_pk_mul_f32 v[54:55], v[54:55], v[8:9] op_sel_hi:[1,0]
    v_pk_mul_f32 v[56:57], v[56:57], v[8:9] op_sel_hi:[1,0]
    v_pk_mul_f32 v[58:59], v[58:59], v[8:9] op_sel_hi:[1,0]
    v_pk_mul_f32 v[60:61], v[60:61], v[8:9] op_sel_hi:[1,0]
    v_pk_mul_f32 v[62:63], v[62:63], v[8:9] op_sel_hi:[1,0]
    v_pk_mul_f32 v[64:65], v[64:65], v[8:9] op_sel_hi:[1,0]
    v_pk_mul_f32 v[66:67], v[66:67], v[8:9] op_sel_hi:[1,0]
    v_pk_mul_f32 v[68:69], v[68:69], v[8:9] op_sel_hi:[1,0]
    v_pk_mul_f32 v[70:71], v[70:71], v[8:9] op_sel_hi:[1,0]
    v_pk_mul_f32 v[72:73], v[72:73], v[8:9] op_sel_hi:[1,0]
    v_pk_mul_f32 v[74:75], v[74:75], v[8:9] op_sel_hi:[1,0]
    s_waitcnt vmcnt(8)
    buffer_load_dwordx4 v[76:79], v1, s[8:11], s21 offen offset:0 nt
    buffer_load_dwordx4 v[80:83], v1, s[8:11], s21 offen offset:64 nt
    buffer_load_dwordx4 v[84:87], v1, s[8:11], s21 offen offset:128 nt
    buffer_load_dwordx4 v[88:91], v1, s[8:11], s21 offen offset:192 nt
    s_add_u32 s21, s21, 16384
    s_nop 0
    v_mfma_f32_16x16x16_bf16 v[44:47], v[92:93], v[20:21], v[44:47]
    v_mfma_f32_16x16x16_bf16 v[48:51], v[92:93], v[22:23], v[48:51]
    v_mfma_f32_16x16x16_bf16 v[52:55], v[94:95], v[20:21], v[52:55]
    v_mfma_f32_16x16x16_bf16 v[56:59], v[94:95], v[22:23], v[56:59]
    v_mfma_f32_16x16x16_bf16 v[60:63], v[96:97], v[20:21], v[60:63]
    v_mfma_f32_16x16x16_bf16 v[64:67], v[96:97], v[22:23], v[64:67]
    v_mfma_f32_16x16x16_bf16 v[68:71], v[98:99], v[20:21], v[68:71]
    v_mfma_f32_16x16x16_bf16 v[72:75], v[98:99], v[22:23], v[72:75]
    v_mfma_f32_16x16x16_bf16 v[44:47], v[100:101], v[24:25], v[44:47]
    v_mfma_f32_16x16x16_bf16 v[48:51], v[100:101], v[26:27], v[48:51]
    v_mfma_f32_16x16x16_bf16 v[52:55], v[102:103], v[24:25], v[52:55]
    v_mfma_f32_16x16x16_bf16 v[56:59], v[102:103], v[26:27], v[56:59]
    v_mfma_f32_16x16x16_bf16 v[60:63], v[104:105], v[24:25], v[60:63]
    v_mfma_f32_16x16x16_bf16 v[64:67], v[104:105], v[26:27], v[64:67]
    v_mfma_f32_16x16x16_bf16 v[68:71], v[106:107], v[24:25], v[68:71]
    v_mfma_f32_16x16x16_bf16 v[72:75], v[106:107], v[26:27], v[72:75]
    s_waitcnt vmcnt(8)
    buffer_load_dwordx4 v[92:95], v2, s[12:15], s53 offen offset:0 nt
    buffer_load_dwordx4 v[96:99], v3, s[12:15], s53 offen offset:0 nt
    buffer_load_dwordx4 v[100:103], v2, s[12:15], s53 offen offset:2048 nt
    buffer_load_dwordx4 v[104:107], v3, s[12:15], s53 offen offset:2048 nt
    s_add_u32 s53, s53, 16384
    ds_write_b128 v205, v[108:111] offset:0
    ds_write_b128 v205, v[112:115] offset:1024
    ds_write_b128 v205, v[116:119] offset:2048
    ds_write_b128 v205, v[120:123] offset:3072
    ds_read_b128 v[108:111], v204 offset:0
    ds_read_b128 v[112:115], v204 offset:1024
    ds_read_b128 v[116:119], v204 offset:2048
    ds_read_b128 v[120:123], v204 offset:3072
    s_waitcnt lgkmcnt(3)
    v_mfma_f32_16x16x32_bf16 v[16:19], v[108:111], v[28:31], 0
    s_waitcnt lgkmcnt(2)
    v_mfma_f32_16x16x32_bf16 v[16:19], v[112:115], v[32:35], v[16:19]
    s_waitcnt lgkmcnt(1)
    v_mfma_f32_16x16x32_bf16 v[16:19], v[116:119], v[36:39], v[16:19]
    s_waitcnt lgkmcnt(0)
    v_mfma_f32_16x16x32_bf16 v[16:19], v[120:123], v[40:43], v[16:19]
    s_nop 7
    v_cndmask_b32 v12, v16, v17, s[26:27]
    v_cndmask_b32 v13, v18, v19, s[26:27]
    v_cvt_pk_bf16_f32 v9, v12, v13
    v_lshlrev_b32 v12, 16, v9
    v_and_b32 v13, 0xffff0000, v9
    v_mul_f32 v12, s55, v12
    v_mul_f32 v13, s55, v13
    v_cvt_pk_bf16_f32 v9, v12, v13
    v_lshlrev_b32 v12, 16, v9
    v_and_b32 v13, 0xffff0000, v9
    v_max_f32 v10, v12, v13
    ds_write_b64 v4, v[12:13]
    v_add_u32 v4, s30, v4
    v_max_f32_dpp v10, v10, v10 row_ror:8 row_mask:0xf bank_mask:0xf
    v_mov_b32 v9, v10
    s_nop 1
    v_permlane16_swap_b32 v10, v9
    v_max_f32 v10, v10, v9
    v_mov_b32 v9, v10
    s_nop 1
    v_permlane32_swap_b32 v10, v9
    v_max_f32 v10, v10, v9
    v_mul_f32 v10, s25, v10
    v_max_f32 v10, v6, v10
    v_sub_f32 v8, v6, v10
    v_fma_f32 v14, v12, s25, -v10
    v_fma_f32 v15, v13, s25, -v10
    v_exp_f32 v8, v8
    v_exp_f32 v14, v14
    v_exp_f32 v15, v15
    v_mov_b32 v6, v10
    v_fma_f32 v7, v7, v8, v14
    v_cvt_pk_bf16_f32 v9, v14, v14
    v_cvt_pk_bf16_f32 v11, v15, v15
    v_add_f32 v7, v7, v15
    v_and_b32 v20, v9, v5
    v_and_b32 v23, v9, v5
    v_and_b32 v24, v11, v5
    v_and_b32 v27, v11, v5
    v_pk_mul_f32 v[44:45], v[44:45], v[8:9] op_sel_hi:[1,0]
    v_pk_mul_f32 v[46:47], v[46:47], v[8:9] op_sel_hi:[1,0]
    v_pk_mul_f32 v[48:49], v[48:49], v[8:9] op_sel_hi:[1,0]
    v_pk_mul_f32 v[50:51], v[50:51], v[8:9] op_sel_hi:[1,0]
    v_pk_mul_f32 v[52:53], v[52:53], v[8:9] op_sel_hi:[1,0]
    v_pk_mul_f32 v[54:55], v[54:55], v[8:9] op_sel_hi:[1,0]
    v_pk_mul_f32 v[56:57], v[56:57], v[8:9] op_sel_hi:[1,0]
    v_pk_mul_f32 v[58:59], v[58:59], v[8:9] op_sel_hi:[1,0]
    v_pk_mul_f32 v[60:61], v[60:61], v[8:9] op_sel_hi:[1,0]
    v_pk_mul_f32 v[62:63], v[62:63], v[8:9] op_sel_hi:[1,0]
    v_pk_mul_f32 v[64:65], v[64:65], v[8:9] op_sel_hi:[1,0]
    v_pk_mul_f32 v[66:67], v[66:67], v[8:9] op_sel_hi:[1,0]
    v_pk_mul_f32 v[68:69], v[68:69], v[8:9] op_sel_hi:[1,0]
    v_pk_mul_f32 v[70:71], v[70:71], v[8:9] op_sel_hi:[1,0]
    v_pk_mul_f32 v[72:73], v[72:73], v[8:9] op_sel_hi:[1,0]
    v_pk_mul_f32 v[74:75], v[74:75], v[8:9] op_sel_hi:[1,0]
    s_waitcnt vmcnt(8)
    buffer_load_dwordx4 v[108:111], v1, s[8:11], s21 offen offset:0 nt
    buffer_load_dwordx4 v[112:115], v1, s[8:11], s21 offen offset:64 nt
    buffer_load_dwordx4 v[116:119], v1, s[8:11], s21 offen offset:128 nt
    buffer_load_dwordx4 v[120:123], v1, s[8:11], s21 offen offset:192 nt
    s_add_u32 s21, s21, 16384
    s_nop 0
    v_mfma_f32_16x16x16_bf16 v[44:47], v[124:125], v[20:21], v[44:47]
    v_mfma_f32_16x16x16_bf16 v[48:51], v[124:125], v[22:23], v[48:51]
    v_mfma_f32_16x16x16_bf16 v[52:55], v[126:127], v[20:21], v[52:55]
    v_mfma_f32_16x16x16_bf16 v[56:59], v[126:127], v[22:23], v[56:59]
    v_mfma_f32_16x16x16_bf16 v[60:63], v[128:129], v[20:21], v[60:63]
    v_mfma_f32_16x16x16_bf16 v[64:67], v[128:129], v[22:23], v[64:67]
    v_mfma_f32_16x16x16_bf16 v[68:71], v[130:131], v[20:21], v[68:71]
    v_mfma_f32_16x16x16_bf16 v[72:75], v[130:131], v[22:23], v[72:75]
    v_mfma_f32_16x16x16_bf16 v[44:47], v[132:133], v[24:25], v[44:47]
    v_mfma_f32_16x16x16_bf16 v[48:51], v[132:133], v[26:27], v[48:51]
    v_mfma_f32_16x16x16_bf16 v[52:55], v[134:135], v[24:25], v[52:55]
    v_mfma_f32_16x16x16_bf16 v[56:59], v[134:135], v[26:27], v[56:59]
    v_mfma_f32_16x16x16_bf16 v[60:63], v[136:137], v[24:25], v[60:63]
    v_mfma_f32_16x16x16_bf16 v[64:67], v[136:137], v[26:27], v[64:67]
    v_mfma_f32_16x16x16_bf16 v[68:71], v[138:139], v[24:25], v[68:71]
    v_mfma_f32_16x16x16_bf16 v[72:75], v[138:139], v[26:27], v[72:75]
    s_add_u32 s24, s24, 1
    s_barrier
    s_cmp_lt_u32 s24, 15
    s_cbranch_scc1 L_loop
    s_waitcnt vmcnt(8)
    buffer_load_dwordx4 v[124:127], v2, s[12:15], s53 offen offset:0 nt
    buffer_load_dwordx4 v[132:135], v2, s[12:15], s53 offen offset:2048 nt
    s_add_u32 s53, s53, 16384
    ds_write_b128 v205, v[76:79] offset:0
    ds_write_b128 v205, v[80:83] offset:1024
    ds_write_b128 v205, v[84:87] offset:2048
    ds_write_b128 v205, v[88:91] offset:3072
    ds_read_b128 v[76:79], v204 offset:0
    ds_read_b128 v[80:83], v204 offset:1024
    ds_read_b128 v[84:87], v204 offset:2048
    ds_read_b128 v[88:91], v204 offset:3072
    s_waitcnt lgkmcnt(3)
    v_mfma_f32_16x16x32_bf16 v[16:19], v[76:79], v[28:31], 0
    s_waitcnt lgkmcnt(2)
    v_mfma_f32_16x16x32_bf16 v[16:19], v[80:83], v[32:35], v[16:19]
    s_waitcnt lgkmcnt(1)
    v_mfma_f32_16x16x32_bf16 v[16:19], v[84:87], v[36:39], v[16:19]
    s_waitcnt lgkmcnt(0)
    v_mfma_f32_16x16x32_bf16 v[16:19], v[88:91], v[40:43], v[16:19]
    s_nop 7
    v_cndmask_b32 v12, v16, v17, s[26:27]
    v_cndmask_b32 v13, v18, v19, s[26:27]
    v_cvt_pk_bf16_f32 v9, v12, v13
    v_lshlrev_b32 v12, 16, v9
    v_and_b32 v13, 0xffff0000, v9
    v_mul_f32 v12, s55, v12
    v_mul_f32 v13, s55, v13
    v_cvt_pk_bf16_f32 v9, v12, v13
    v_lshlrev_b32 v12, 16, v9
    v_and_b32 v13, 0xffff0000, v9
    v_max_f32 v10, v12, v13
    s_nop 1
    v_max_f32_dpp v10, v10, v10 row_ror:8 row_mask:0xf bank_mask:0xf
    v_mov_b32 v9, v10
    s_nop 1
    v_permlane16_swap_b32 v10, v9
    v_max_f32 v10, v10, v9
    v_mov_b32 v9, v10
    s_nop 1
    v_permlane32_swap_b32 v10, v9
    v_max_f32 v10, v10, v9
    v_mul_f32 v10, s25, v10
    v_max_f32 v10, v6, v10
    v_sub_f32 v8, v6, v10
    v_fma_f32 v14, v12, s25, -v10
    v_fma_f32 v15, v13, s25, -v10
    v_exp_f32 v8, v8
    v_exp_f32 v14, v14
    v_exp_f32 v15, v15
    v_mov_b32 v6, v10
    v_fma_f32 v7, v7, v8, v14
    v_cvt_pk_bf16_f32 v9, v14, v14
    v_cvt_pk_bf16_f32 v11, v15, v15
    v_add_f32 v7, v7, v15
    v_and_b32 v20, v9, v5
    v_and_b32 v23, v9, v5
    v_and_b32 v24, v11, v5
    v_and_b32 v27, v11, v5
    v_pk_mul_f32 v[44:45], v[44:45], v[8:9] op_sel_hi:[1,0]
    v_pk_mul_f32 v[46:47], v[46:47], v[8:9] op_sel_hi:[1,0]
    v_pk_mul_f32 v[48:49], v[48:49], v[8:9] op_sel_hi:[1,0]
    v_pk_mul_f32 v[50:51], v[50:51], v[8:9] op_sel_hi:[1,0]
    v_pk_mul_f32 v[52:53], v[52:53], v[8:9] op_sel_hi:[1,0]
    v_pk_mul_f32 v[54:55], v[54:55], v[8:9] op_sel_hi:[1,0]
    v_pk_mul_f32 v[56:57], v[56:57], v[8:9] op_sel_hi:[1,0]
    v_pk_mul_f32 v[58:59], v[58:59], v[8:9] op_sel_hi:[1,0]
    v_pk_mul_f32 v[60:61], v[60:61], v[8:9] op_sel_hi:[1,0]
    v_pk_mul_f32 v[62:63], v[62:63], v[8:9] op_sel_hi:[1,0]
    v_pk_mul_f32 v[64:65], v[64:65], v[8:9] op_sel_hi:[1,0]
    v_pk_mul_f32 v[66:67], v[66:67], v[8:9] op_sel_hi:[1,0]
    v_pk_mul_f32 v[68:69], v[68:69], v[8:9] op_sel_hi:[1,0]
    v_pk_mul_f32 v[70:71], v[70:71], v[8:9] op_sel_hi:[1,0]
    v_pk_mul_f32 v[72:73], v[72:73], v[8:9] op_sel_hi:[1,0]
    v_pk_mul_f32 v[74:75], v[74:75], v[8:9] op_sel_hi:[1,0]
    s_waitcnt vmcnt(6)
    buffer_load_dwordx4 v[140:143], v3, s[12:15], s23 offen offset:0 nt
    buffer_load_dwordx4 v[144:147], v3, s[12:15], s23 offen offset:2048 nt
    s_add_u32 s23, s23, 65536
    buffer_load_dwordx4 v[148:151], v3, s[12:15], s23 offen offset:0 nt
    buffer_load_dwordx4 v[152:155], v3, s[12:15], s23 offen offset:2048 nt
    s_add_u32 s23, s23, 65536
    s_nop 0
    v_mfma_f32_16x16x16_bf16 v[44:47], v[92:93], v[20:21], v[44:47]
    v_mfma_f32_16x16x16_bf16 v[48:51], v[92:93], v[22:23], v[48:51]
    v_mfma_f32_16x16x16_bf16 v[52:55], v[94:95], v[20:21], v[52:55]
    v_mfma_f32_16x16x16_bf16 v[56:59], v[94:95], v[22:23], v[56:59]
    v_mfma_f32_16x16x16_bf16 v[60:63], v[96:97], v[20:21], v[60:63]
    v_mfma_f32_16x16x16_bf16 v[64:67], v[96:97], v[22:23], v[64:67]
    v_mfma_f32_16x16x16_bf16 v[68:71], v[98:99], v[20:21], v[68:71]
    v_mfma_f32_16x16x16_bf16 v[72:75], v[98:99], v[22:23], v[72:75]
    v_mfma_f32_16x16x16_bf16 v[44:47], v[100:101], v[24:25], v[44:47]
    v_mfma_f32_16x16x16_bf16 v[48:51], v[100:101], v[26:27], v[48:51]
    v_mfma_f32_16x16x16_bf16 v[52:55], v[102:103], v[24:25], v[52:55]
    v_mfma_f32_16x16x16_bf16 v[56:59], v[102:103], v[26:27], v[56:59]
    v_mfma_f32_16x16x16_bf16 v[60:63], v[104:105], v[24:25], v[60:63]
    v_mfma_f32_16x16x16_bf16 v[64:67], v[104:105], v[26:27], v[64:67]
    v_mfma_f32_16x16x16_bf16 v[68:71], v[106:107], v[24:25], v[68:71]
    v_mfma_f32_16x16x16_bf16 v[72:75], v[106:107], v[26:27], v[72:75]
    s_waitcnt vmcnt(6)
    buffer_load_dwordx4 v[156:159], v3, s[12:15], s23 offen offset:0 nt
    buffer_load_dwordx4 v[160:163], v3, s[12:15], s23 offen offset:2048 nt
    s_add_u32 s23, s23, 65536
    buffer_load_dwordx4 v[164:167], v3, s[12:15], s23 offen offset:0 nt
    buffer_load_dwordx4 v[168:171], v3, s[12:15], s23 offen offset:2048 nt
    s_add_u32 s23, s23, 65536
    ds_write_b128 v205, v[108:111] offset:0
    ds_write_b128 v205, v[112:115] offset:1024
    ds_write_b128 v205, v[116:119] offset:2048
    ds_write_b128 v205, v[120:123] offset:3072
    ds_read_b128 v[108:111], v204 offset:0
    ds_read_b128 v[112:115], v204 offset:1024
    ds_read_b128 v[116:119], v204 offset:2048
    ds_read_b128 v[120:123], v204 offset:3072
    s_waitcnt lgkmcnt(3)
    v_mfma_f32_16x16x32_bf16 v[16:19], v[108:111], v[28:31], 0
    s_waitcnt lgkmcnt(2)
    v_mfma_f32_16x16x32_bf16 v[16:19], v[112:115], v[32:35], v[16:19]
    s_waitcnt lgkmcnt(1)
    v_mfma_f32_16x16x32_bf16 v[16:19], v[116:119], v[36:39], v[16:19]
    s_waitcnt lgkmcnt(0)
    v_mfma_f32_16x16x32_bf16 v[16:19], v[120:123], v[40:43], v[16:19]
    s_nop 7
    v_cndmask_b32 v12, v16, v17, s[26:27]
    v_cndmask_b32 v13, v18, v19, s[26:27]
    v_cvt_pk_bf16_f32 v9, v12, v13
    v_lshlrev_b32 v12, 16, v9
    v_and_b32 v13, 0xffff0000, v9
    v_mul_f32 v12, s55, v12
    v_mul_f32 v13, s55, v13
    v_cvt_pk_bf16_f32 v9, v12, v13
    v_lshlrev_b32 v12, 16, v9
    v_and_b32 v13, 0xffff0000, v9
    v_max_f32 v10, v12, v13
    ds_write_b64 v4, v[12:13]
    v_add_u32 v4, 512, v4
    v_max_f32_dpp v10, v10, v10 row_ror:8 row_mask:0xf bank_mask:0xf
    v_mov_b32 v9, v10
    s_nop 1
    v_permlane16_swap_b32 v10, v9
    v_max_f32 v10, v10, v9
    v_mov_b32 v9, v10
    s_nop 1
    v_permlane32_swap_b32 v10, v9
    v_max_f32 v10, v10, v9
    v_mul_f32 v10, s25, v10
    v_max_f32 v10, v6, v10
    v_sub_f32 v8, v6, v10
    v_fma_f32 v14, v12, s25, -v10
    v_fma_f32 v15, v13, s25, -v10
    v_exp_f32 v8, v8
    v_exp_f32 v14, v14
    v_exp_f32 v15, v15
    v_mov_b32 v6, v10
    v_fma_f32 v7, v7, v8, v14
    v_cvt_pk_bf16_f32 v9, v14, v14
    v_cvt_pk_bf16_f32 v11, v15, v15
    v_add_f32 v7, v7, v15
    v_and_b32 v20, v9, v5
    v_and_b32 v23, v9, v5
    v_and_b32 v24, v11, v5
    v_and_b32 v27, v11, v5
    v_pk_mul_f32 v[44:45], v[44:45], v[8:9] op_sel_hi:[1,0]
    v_pk_mul_f32 v[46:47], v[46:47], v[8:9] op_sel_hi:[1,0]
    v_pk_mul_f32 v[48:49], v[48:49], v[8:9] op_sel_hi:[1,0]
    v_pk_mul_f32 v[50:51], v[50:51], v[8:9] op_sel_hi:[1,0]
    v_pk_mul_f32 v[52:53], v[52:53], v[8:9] op_sel_hi:[1,0]
    v_pk_mul_f32 v[54:55], v[54:55], v[8:9] op_sel_hi:[1,0]
    v_pk_mul_f32 v[56:57], v[56:57], v[8:9] op_sel_hi:[1,0]
    v_pk_mul_f32 v[58:59], v[58:59], v[8:9] op_sel_hi:[1,0]
    v_pk_mul_f32 v[60:61], v[60:61], v[8:9] op_sel_hi:[1,0]
    v_pk_mul_f32 v[62:63], v[62:63], v[8:9] op_sel_hi:[1,0]
    v_pk_mul_f32 v[64:65], v[64:65], v[8:9] op_sel_hi:[1,0]
    v_pk_mul_f32 v[66:67], v[66:67], v[8:9] op_sel_hi:[1,0]
    v_pk_mul_f32 v[68:69], v[68:69], v[8:9] op_sel_hi:[1,0]
    v_pk_mul_f32 v[70:71], v[70:71], v[8:9] op_sel_hi:[1,0]
    v_pk_mul_f32 v[72:73], v[72:73], v[8:9] op_sel_hi:[1,0]
    v_pk_mul_f32 v[74:75], v[74:75], v[8:9] op_sel_hi:[1,0]
    s_waitcnt vmcnt(8)
    buffer_load_dwordx4 v[172:175], v3, s[12:15], s23 offen offset:0 nt
    buffer_load_dwordx4 v[176:179], v3, s[12:15], s23 offen offset:2048 nt
    s_add_u32 s23, s23, 65536
    buffer_load_dwordx4 v[180:183], v3, s[12:15], s23 offen offset:0 nt
    buffer_load_dwordx4 v[184:187], v3, s[12:15], s23 offen offset:2048 nt
    s_add_u32 s23, s23, 65536
    s_nop 0
    v_mfma_f32_16x16x16_bf16 v[44:47], v[124:125], v[20:21], v[44:47]
    v_mfma_f32_16x16x16_bf16 v[48:51], v[124:125], v[22:23], v[48:51]
    v_mfma_f32_16x16x16_bf16 v[52:55], v[126:127], v[20:21], v[52:55]
    v_mfma_f32_16x16x16_bf16 v[56:59], v[126:127], v[22:23], v[56:59]
    v_mfma_f32_16x16x16_bf16 v[44:47], v[132:133], v[24:25], v[44:47]
    v_mfma_f32_16x16x16_bf16 v[48:51], v[132:133], v[26:27], v[48:51]
    v_mfma_f32_16x16x16_bf16 v[52:55], v[134:135], v[24:25], v[52:55]
    v_mfma_f32_16x16x16_bf16 v[56:59], v[134:135], v[26:27], v[56:59]
    v_add_f32_dpp v7, v7, v7 row_ror:8 row_mask:0xf bank_mask:0xf
    v_mov_b32 v9, v7
    s_nop 1
    v_permlane16_swap_b32 v7, v9
    v_add_f32 v7, v7, v9
    v_mov_b32 v9, v7
    s_nop 1
    v_permlane32_swap_b32 v7, v9
    v_add_f32 v7, v7, v9
    s_lshl_b32 s22, s20, 9
    v_lshlrev_b32 v11, 3, v0
    v_add_u32 v4, s52, v11
    v_add_u32 v11, s22, v11
    ds_write_b64 v11, v[6:7] offset:64
    v_lshrrev_b32 v9, 5, v0
    v_lshlrev_b32 v9, 10, v9
    v_bfe_u32 v11, v0, 4, 1
    v_lshl_or_b32 v9, v11, 7, v9
    v_and_b32 v11, 7, v0
    v_lshl_or_b32 v9, v11, 4, v9
    s_lshl_b32 s22, s20, 11
    v_add_u32 v0, s22, v9
    v_mov_b32 v9, 0
    v_mov_b32 v11, 1
    s_mov_b64 exec, s[28:29]
    ds_write_b128 v0, v[44:47] offset:2112
    ds_write_b128 v0, v[48:51] offset:2368
    ds_write_b128 v0, v[52:55] offset:2624
    ds_write_b128 v0, v[56:59] offset:2880
    s_mov_b64 exec, 1
    ds_add_u32 v9, v11 offset:0
    s_mov_b64 exec, -1
    v_mov_b32 v29, 0
    v_mov_b32 v30, 0
    v_mov_b32 v33, 0
    v_mov_b32 v34, 0
    v_mov_b32 v37, 0
    v_mov_b32 v38, 0
    v_mov_b32 v41, 0
    v_mov_b32 v42, 0
    ds_read_b64 v[16:17], v4 offset:0
    ds_read_b64 v[18:19], v4 offset:512
    s_waitcnt lgkmcnt(0)
    v_fma_f32 v16, v16, s25, -v6
    v_fma_f32 v17, v17, s25, -v6
    v_fma_f32 v18, v18, s25, -v6
    v_fma_f32 v19, v19, s25, -v6
    v_exp_f32 v16, v16
    v_exp_f32 v17, v17
    v_exp_f32 v18, v18
    v_exp_f32 v19, v19
    s_nop 0
    v_cvt_pk_bf16_f32 v16, v16, v16
    v_cvt_pk_bf16_f32 v17, v17, v17
    v_cvt_pk_bf16_f32 v18, v18, v18
    v_cvt_pk_bf16_f32 v19, v19, v19
    v_and_b32 v28, v16, v5
    v_and_b32 v31, v16, v5
    v_and_b32 v32, v17, v5
    v_and_b32 v35, v17, v5
    v_and_b32 v36, v18, v5
    v_and_b32 v39, v18, v5
    v_and_b32 v40, v19, v5
    v_and_b32 v43, v19, v5
    s_nop 0
    s_waitcnt vmcnt(11)
    v_mfma_f32_16x16x16_bf16 v[60:63], v[140:141], v[28:29], v[60:63]
    v_mfma_f32_16x16x16_bf16 v[64:67], v[140:141], v[30:31], v[64:67]
    v_mfma_f32_16x16x16_bf16 v[68:71], v[142:143], v[28:29], v[68:71]
    v_mfma_f32_16x16x16_bf16 v[72:75], v[142:143], v[30:31], v[72:75]
    s_waitcnt vmcnt(10)
    v_mfma_f32_16x16x16_bf16 v[60:63], v[144:145], v[32:33], v[60:63]
    v_mfma_f32_16x16x16_bf16 v[64:67], v[144:145], v[34:35], v[64:67]
    v_mfma_f32_16x16x16_bf16 v[68:71], v[146:147], v[32:33], v[68:71]
    v_mfma_f32_16x16x16_bf16 v[72:75], v[146:147], v[34:35], v[72:75]
    s_waitcnt vmcnt(9)
    v_mfma_f32_16x16x16_bf16 v[60:63], v[148:149], v[36:37], v[60:63]
    v_mfma_f32_16x16x16_bf16 v[64:67], v[148:149], v[38:39], v[64:67]
    v_mfma_f32_16x16x16_bf16 v[68:71], v[150:151], v[36:37], v[68:71]
    v_mfma_f32_16x16x16_bf16 v[72:75], v[150:151], v[38:39], v[72:75]
    s_waitcnt vmcnt(8)
    v_mfma_f32_16x16x16_bf16 v[60:63], v[152:153], v[40:41], v[60:63]
    v_mfma_f32_16x16x16_bf16 v[64:67], v[152:153], v[42:43], v[64:67]
    v_mfma_f32_16x16x16_bf16 v[68:71], v[154:155], v[40:41], v[68:71]
    v_mfma_f32_16x16x16_bf16 v[72:75], v[154:155], v[42:43], v[72:75]
    buffer_load_dwordx4 v[188:191], v3, s[12:15], s23 offen offset:0 nt
    buffer_load_dwordx4 v[192:195], v3, s[12:15], s23 offen offset:2048 nt
    s_add_u32 s23, s23, 65536
    buffer_load_dwordx4 v[196:199], v3, s[12:15], s23 offen offset:0 nt
    buffer_load_dwordx4 v[200:203], v3, s[12:15], s23 offen offset:2048 nt
    s_add_u32 s23, s23, 65536
    ds_read_b64 v[16:17], v4 offset:1024
    ds_read_b64 v[18:19], v4 offset:1536
    s_waitcnt lgkmcnt(0)
    v_fma_f32 v16, v16, s25, -v6
    v_fma_f32 v17, v17, s25, -v6
    v_fma_f32 v18, v18, s25, -v6
    v_fma_f32 v19, v19, s25, -v6
    v_exp_f32 v16, v16
    v_exp_f32 v17, v17
    v_exp_f32 v18, v18
    v_exp_f32 v19, v19
    s_nop 0
    v_cvt_pk_bf16_f32 v16, v16, v16
    v_cvt_pk_bf16_f32 v17, v17, v17
    v_cvt_pk_bf16_f32 v18, v18, v18
    v_cvt_pk_bf16_f32 v19, v19, v19
    v_and_b32 v28, v16, v5
    v_and_b32 v31, v16, v5
    v_and_b32 v32, v17, v5
    v_and_b32 v35, v17, v5
    v_and_b32 v36, v18, v5
    v_and_b32 v39, v18, v5
    v_and_b32 v40, v19, v5
    v_and_b32 v43, v19, v5
    s_nop 0
    s_waitcnt vmcnt(11)
    v_mfma_f32_16x16x16_bf16 v[60:63], v[156:157], v[28:29], v[60:63]
    v_mfma_f32_16x16x16_bf16 v[64:67], v[156:157], v[30:31], v[64:67]
    v_mfma_f32_16x16x16_bf16 v[68:71], v[158:159], v[28:29], v[68:71]
    v_mfma_f32_16x16x16_bf16 v[72:75], v[158:159], v[30:31], v[72:75]
    s_waitcnt vmcnt(10)
    v_mfma_f32_16x16x16_bf16 v[60:63], v[160:161], v[32:33], v[60:63]
    v_mfma_f32_16x16x16_bf16 v[64:67], v[160:161], v[34:35], v[64:67]
    v_mfma_f32_16x16x16_bf16 v[68:71], v[162:163], v[32:33], v[68:71]
    v_mfma_f32_16x16x16_bf16 v[72:75], v[162:163], v[34:35], v[72:75]
    s_waitcnt vmcnt(9)
    v_mfma_f32_16x16x16_bf16 v[60:63], v[164:165], v[36:37], v[60:63]
    v_mfma_f32_16x16x16_bf16 v[64:67], v[164:165], v[38:39], v[64:67]
    v_mfma_f32_16x16x16_bf16 v[68:71], v[166:167], v[36:37], v[68:71]
    v_mfma_f32_16x16x16_bf16 v[72:75], v[166:167], v[38:39], v[72:75]
    s_waitcnt vmcnt(8)
    v_mfma_f32_16x16x16_bf16 v[60:63], v[168:169], v[40:41], v[60:63]
    v_mfma_f32_16x16x16_bf16 v[64:67], v[168:169], v[42:43], v[64:67]
    v_mfma_f32_16x16x16_bf16 v[68:71], v[170:171], v[40:41], v[68:71]
    v_mfma_f32_16x16x16_bf16 v[72:75], v[170:171], v[42:43], v[72:75]
    ds_read_b64 v[16:17], v4 offset:2048
    ds_read_b64 v[18:19], v4 offset:2560
    s_waitcnt lgkmcnt(0)
    v_fma_f32 v16, v16, s25, -v6
    v_fma_f32 v17, v17, s25, -v6
    v_fma_f32 v18, v18, s25, -v6
    v_fma_f32 v19, v19, s25, -v6
    v_exp_f32 v16, v16
    v_exp_f32 v17, v17
    v_exp_f32 v18, v18
    v_exp_f32 v19, v19
    s_nop 0
    v_cvt_pk_bf16_f32 v16, v16, v16
    v_cvt_pk_bf16_f32 v17, v17, v17
    v_cvt_pk_bf16_f32 v18, v18, v18
    v_cvt_pk_bf16_f32 v19, v19, v19
    v_and_b32 v28, v16, v5
    v_and_b32 v31, v16, v5
    v_and_b32 v32, v17, v5
    v_and_b32 v35, v17, v5
    v_and_b32 v36, v18, v5
    v_and_b32 v39, v18, v5
    v_and_b32 v40, v19, v5
    v_and_b32 v43, v19, v5
    s_nop 0
    s_waitcnt vmcnt(7)
    v_mfma_f32_16x16x16_bf16 v[60:63], v[172:173], v[28:29], v[60:63]
    v_mfma_f32_16x16x16_bf16 v[64:67], v[172:173], v[30:31], v[64:67]
    v_mfma_f32_16x16x16_bf16 v[68:71], v[174:175], v[28:29], v[68:71]
    v_mfma_f32_16x16x16_bf16 v[72:75], v[174:175], v[30:31], v[72:75]
    s_waitcnt vmcnt(6)
    v_mfma_f32_16x16x16_bf16 v[60:63], v[176:177], v[32:33], v[60:63]
    v_mfma_f32_16x16x16_bf16 v[64:67], v[176:177], v[34:35], v[64:67]
    v_mfma_f32_16x16x16_bf16 v[68:71], v[178:179], v[32:33], v[68:71]
    v_mfma_f32_16x16x16_bf16 v[72:75], v[178:179], v[34:35], v[72:75]
    s_waitcnt vmcnt(5)
    v_mfma_f32_16x16x16_bf16 v[60:63], v[180:181], v[36:37], v[60:63]
    v_mfma_f32_16x16x16_bf16 v[64:67], v[180:181], v[38:39], v[64:67]
    v_mfma_f32_16x16x16_bf16 v[68:71], v[182:183], v[36:37], v[68:71]
    v_mfma_f32_16x16x16_bf16 v[72:75], v[182:183], v[38:39], v[72:75]
    s_waitcnt vmcnt(4)
    v_mfma_f32_16x16x16_bf16 v[60:63], v[184:185], v[40:41], v[60:63]
    v_mfma_f32_16x16x16_bf16 v[64:67], v[184:185], v[42:43], v[64:67]
    v_mfma_f32_16x16x16_bf16 v[68:71], v[186:187], v[40:41], v[68:71]
    v_mfma_f32_16x16x16_bf16 v[72:75], v[186:187], v[42:43], v[72:75]
    ds_read_b64 v[16:17], v4 offset:3072
    ds_read_b64 v[18:19], v4 offset:3584
    s_waitcnt lgkmcnt(0)
    v_fma_f32 v16, v16, s25, -v6
    v_fma_f32 v17, v17, s25, -v6
    v_fma_f32 v18, v18, s25, -v6
    v_fma_f32 v19, v19, s25, -v6
    v_exp_f32 v16, v16
    v_exp_f32 v17, v17
    v_exp_f32 v18, v18
    v_exp_f32 v19, v19
    s_nop 0
    v_cvt_pk_bf16_f32 v16, v16, v16
    v_cvt_pk_bf16_f32 v17, v17, v17
    v_cvt_pk_bf16_f32 v18, v18, v18
    v_cvt_pk_bf16_f32 v19, v19, v19
    v_and_b32 v28, v16, v5
    v_and_b32 v31, v16, v5
    v_and_b32 v32, v17, v5
    v_and_b32 v35, v17, v5
    v_and_b32 v36, v18, v5
    v_and_b32 v39, v18, v5
    v_and_b32 v40, v19, v5
    v_and_b32 v43, v19, v5
    s_nop 0
    s_waitcnt vmcnt(3)
    v_mfma_f32_16x16x16_bf16 v[60:63], v[188:189], v[28:29], v[60:63]
    v_mfma_f32_16x16x16_bf16 v[64:67], v[188:189], v[30:31], v[64:67]
    v_mfma_f32_16x16x16_bf16 v[68:71], v[190:191], v[28:29], v[68:71]
    v_mfma_f32_16x16x16_bf16 v[72:75], v[190:191], v[30:31], v[72:75]
    s_waitcnt vmcnt(2)
    v_mfma_f32_16x16x16_bf16 v[60:63], v[192:193], v[32:33], v[60:63]
    v_mfma_f32_16x16x16_bf16 v[64:67], v[192:193], v[34:35], v[64:67]
    v_mfma_f32_16x16x16_bf16 v[68:71], v[194:195], v[32:33], v[68:71]
    v_mfma_f32_16x16x16_bf16 v[72:75], v[194:195], v[34:35], v[72:75]
    s_waitcnt vmcnt(1)
    v_mfma_f32_16x16x16_bf16 v[60:63], v[196:197], v[36:37], v[60:63]
    v_mfma_f32_16x16x16_bf16 v[64:67], v[196:197], v[38:39], v[64:67]
    v_mfma_f32_16x16x16_bf16 v[68:71], v[198:199], v[36:37], v[68:71]
    v_mfma_f32_16x16x16_bf16 v[72:75], v[198:199], v[38:39], v[72:75]
    s_waitcnt vmcnt(0)
    v_mfma_f32_16x16x16_bf16 v[60:63], v[200:201], v[40:41], v[60:63]
    v_mfma_f32_16x16x16_bf16 v[64:67], v[200:201], v[42:43], v[64:67]
    v_mfma_f32_16x16x16_bf16 v[68:71], v[202:203], v[40:41], v[68:71]
    v_mfma_f32_16x16x16_bf16 v[72:75], v[202:203], v[42:43], v[72:75]
    s_nop 6
    s_mov_b64 exec, s[28:29]
    ds_write_b128 v0, v[60:63] offset:10304
    ds_write_b128 v0, v[64:67] offset:10560
    ds_write_b128 v0, v[68:71] offset:10816
    ds_write_b128 v0, v[72:75] offset:11072
    s_mov_b64 exec, 1
    ds_add_u32 v9, v11 offset:4
    s_mov_b64 exec, -1
    s_endpgm
L_helper:
    s_load_dwordx2 s[32:33], s[0:1], 40
    s_load_dwordx2 s[40:41], s[0:1], 24
    v_mov_b32 v1, 0
    v_mov_b32 v2, 0
    v_mov_b32 v3, 0
    ds_write_b64 v1, v[2:3]
    s_mov_b32 s34, 0x20000000
    s_mov_b32 s35, 0x20000
    s_mov_b32 s42, 0x20000
    s_mov_b32 s43, 0x20000
    v_lshlrev_b32 v5, 4, v0
    v_lshlrev_b32 v6, 3, v0
    v_bfe_u32 v8, v0, 1, 2
    v_lshlrev_b32 v10, 4, v8
    s_lshl_b32 s45, s2, 11
    s_xor_b32 s46, s45, 2048
    s_waitcnt lgkmcnt(0)
    buffer_load_dwordx4 v[16:19], v5, s[32:35], s45 offen sc1
    buffer_load_dwordx4 v[20:23], v10, s[32:35], s45 offen offset:1024 sc1
    v_add_u32 v7, 2112, v5
    v_lshlrev_b32 v8, 8, v8
    v_bfe_u32 v9, v0, 3, 1
    v_lshl_or_b32 v8, v9, 6, v8
    v_lshrrev_b32 v9, 4, v0
    v_lshl_or_b32 v8, v9, 2, v8
    v_and_b32 v9, 1, v0
    v_lshl_or_b32 v8, v9, 1, v8
    s_lshl_b32 s44, s31, 10
    s_lshl_b32 s22, s30, 7
    s_add_u32 s44, s44, s22
    s_mov_b32 s54, 0x05030201
    s_mov_b32 s55, 0x06050302
    s_mov_b32 s56, 0x07060503
    s_mov_b32 s57, 0x0504030c
    s_mov_b32 s59, 0x0403020c
    s_barrier
    s_waitcnt vmcnt(0)
    s_mov_b32 s47, 0
L_hnonce:
    s_add_u32 s47, s47, 1
    s_nop 0
    v_cmp_eq_u32 vcc, s47, v19
    v_cmp_eq_u32 s[48:49], s47, v23
    s_nop 0
    s_or_b64 vcc, vcc, s[48:49]
    s_cbranch_scc1 L_hnonce
    v_mov_b32 v30, s47
    s_mov_b64 exec, 1
    buffer_store_dword v30, v1, s[32:35], s46 offen offset:1152 sc1
    s_mov_b64 exec, -1
    s_barrier
    s_barrier
    s_barrier
    s_barrier
    s_barrier
    s_barrier
    s_barrier
    s_barrier
    s_barrier
    s_barrier
    s_barrier
    s_barrier
    s_barrier
    s_barrier
    s_waitcnt vmcnt(0)
    buffer_load_dword v35, v1, s[32:35], s45 offen offset:1152 sc1
    s_mov_b32 s50, 0x400000
L_hpoll1:
    ds_read_b32 v12, v1
    s_waitcnt lgkmcnt(0)
    v_readfirstlane_b32 s22, v12
    s_sub_u32 s50, s50, 1
    s_cbranch_scc1 L_end
    s_cmp_ge_u32 s22, 4
    s_cbranch_scc1 L_hgo1
    s_sleep 1
    s_branch L_hpoll1
L_hgo1:
    ds_read_b64 v[64:65], v6 offset:64
    ds_read_b64 v[66:67], v6 offset:576
    ds_read_b64 v[68:69], v6 offset:1088
    ds_read_b64 v[70:71], v6 offset:1600
    s_waitcnt lgkmcnt(0)
    v_max_f32 v28, v64, v66
    v_max3_f32 v28, v28, v68, v70
    v_sub_f32 v40, v64, v28
    v_sub_f32 v42, v66, v28
    v_sub_f32 v44, v68, v28
    v_sub_f32 v46, v70, v28
    v_exp_f32 v40, v40
    v_exp_f32 v42, v42
    v_exp_f32 v44, v44
    v_exp_f32 v46, v46
    s_nop 0
    v_mul_f32 v29, v40, v65
    v_fma_f32 v29, v42, v67, v29
    v_fma_f32 v29, v44, v69, v29
    v_fma_f32 v29, v46, v71, v29
    s_mov_b32 s51, 0
L_hred:
    ds_read_b128 v[64:67], v7 offset:0
    ds_read_b128 v[68:71], v7 offset:1024
    ds_read_b128 v[72:75], v7 offset:2048
    ds_read_b128 v[76:79], v7 offset:3072
    ds_read_b128 v[80:83], v7 offset:4096
    ds_read_b128 v[84:87], v7 offset:5120
    ds_read_b128 v[88:91], v7 offset:6144
    ds_read_b128 v[92:95], v7 offset:7168
    s_waitcnt lgkmcnt(7)
    v_pk_mul_f32 v[24:25], v[64:65], v[40:41] op_sel_hi:[1,0]
    v_pk_mul_f32 v[26:27], v[66:67], v[40:41] op_sel_hi:[1,0]
    s_waitcnt lgkmcnt(6)
    v_pk_fma_f32 v[24:25], v[68:69], v[40:41], v[24:25] op_sel_hi:[1,0,1]
    v_pk_fma_f32 v[26:27], v[70:71], v[40:41], v[26:27] op_sel_hi:[1,0,1]
    s_waitcnt lgkmcnt(5)
    v_pk_fma_f32 v[24:25], v[72:73], v[42:43], v[24:25] op_sel_hi:[1,0,1]
    v_pk_fma_f32 v[26:27], v[74:75], v[42:43], v[26:27] op_sel_hi:[1,0,1]
    s_waitcnt lgkmcnt(4)
    v_pk_fma_f32 v[24:25], v[76:77], v[42:43], v[24:25] op_sel_hi:[1,0,1]
    v_pk_fma_f32 v[26:27], v[78:79], v[42:43], v[26:27] op_sel_hi:[1,0,1]
    s_waitcnt lgkmcnt(3)
    v_pk_fma_f32 v[24:25], v[80:81], v[44:45], v[24:25] op_sel_hi:[1,0,1]
    v_pk_fma_f32 v[26:27], v[82:83], v[44:45], v[26:27] op_sel_hi:[1,0,1]
    s_waitcnt lgkmcnt(2)
    v_pk_fma_f32 v[24:25], v[84:85], v[44:45], v[24:25] op_sel_hi:[1,0,1]
    v_pk_fma_f32 v[26:27], v[86:87], v[44:45], v[26:27] op_sel_hi:[1,0,1]
    s_waitcnt lgkmcnt(1)
    v_pk_fma_f32 v[24:25], v[88:89], v[46:47], v[24:25] op_sel_hi:[1,0,1]
    v_pk_fma_f32 v[26:27], v[90:91], v[46:47], v[26:27] op_sel_hi:[1,0,1]
    s_waitcnt lgkmcnt(0)
    v_pk_fma_f32 v[24:25], v[92:93], v[46:47], v[24:25] op_sel_hi:[1,0,1]
    v_pk_fma_f32 v[26:27], v[94:95], v[46:47], v[26:27] op_sel_hi:[1,0,1]
    s_cmp_eq_u32 s51, 0
    s_cbranch_scc0 L_hred_done
    v_add_u32 v24, 0x80, v24
    v_add_u32 v25, 0x80, v25
    v_add_u32 v26, 0x80, v26
    v_add_u32 v27, 0x80, v27
    v_perm_b32 v32, v25, v24, s54
    v_perm_b32 v33, v26, v25, s55
    v_perm_b32 v34, v27, v26, s56
    v_add_u32 v7, 8192, v7
    s_mov_b32 s51, 1
    s_mov_b32 s50, 0x200000
    s_waitcnt vmcnt(0)
    v_mov_b32 v31, v35
    buffer_store_dwordx4 v[32:35], v5, s[32:35], s46 offen sc1
    s_mov_b64 exec, 0x55
    buffer_store_dwordx4 v[28:31], v10, s[32:35], s46 offen offset:1024 sc1
    s_mov_b64 exec, -1
    s_mov_b32 s53, 0
L_hmsg:
    buffer_load_dwordx4 v[16:19], v5, s[32:35], s45 offen sc1
    buffer_load_dwordx4 v[20:23], v10, s[32:35], s45 offen offset:1024 sc1
    s_sub_u32 s50, s50, 1
    s_cbranch_scc1 L_end
    s_waitcnt vmcnt(0)
    v_cmp_ne_u32 vcc, s47, v19
    v_cmp_ne_u32 s[48:49], s47, v23
    s_nop 0
    s_or_b64 vcc, vcc, s[48:49]
    s_cbranch_scc0 L_hgot
    s_cmp_eq_u32 s51, 2
    s_cbranch_scc1 L_hmsg
L_hacc:
    ds_read_b32 v12, v1 offset:4
    s_waitcnt lgkmcnt(0)
    v_readfirstlane_b32 s22, v12
    s_nop 0
    s_cmp_ge_u32 s22, 4
    s_cbranch_scc1 L_hacc_go
    s_cmp_eq_u32 s53, 0
    s_cbranch_scc1 L_hmsg
    s_sub_u32 s50, s50, 1
    s_cbranch_scc1 L_end
    s_sleep 1
    s_branch L_hacc
L_hacc_go:
    s_branch L_hred
L_hred_done:
    s_mov_b32 s51, 2
    s_cmp_eq_u32 s53, 0
    s_cbranch_scc1 L_hmsg
    s_branch L_hout
L_hgot:
    v_cmp_ne_u32 vcc, v22, v35
    v_max_f32 v13, v28, v20
    v_sub_f32 v14, v28, v13
    v_sub_f32 v15, v20, v13
    v_exp_f32 v14, v14
    v_exp_f32 v15, v15
    s_cbranch_vccz L_hnoresend
    v_mov_b32 v35, v22
    v_mov_b32 v31, v22
    buffer_store_dwordx4 v[32:35], v5, s[32:35], s46 offen sc1
    s_mov_b64 exec, 0x55
    buffer_store_dwordx4 v[28:31], v10, s[32:35], s46 offen offset:1024 sc1
    s_mov_b64 exec, -1
L_hnoresend:
    v_mul_f32 v11, v14, v29
    v_fma_f32 v11, v15, v21, v11
    v_rcp_f32 v11, v11
    v_lshlrev_b32 v36, 8, v16
    v_perm_b32 v37, v17, v16, s57
    v_perm_b32 v38, v18, v17, s59
    v_and_b32 v39, 0xffffff00, v18
    v_mul_f32 v14, v14, v11
    v_mul_f32 v15, v15, v11
    v_mul_f32 v36, v36, v15
    v_mul_f32 v37, v37, v15
    v_mul_f32 v38, v38, v15
    v_mul_f32 v39, v39, v15
    s_mov_b32 s53, 1
    s_cmp_eq_u32 s51, 2
    s_cbranch_scc0 L_hacc
L_hout:
    v_fma_f32 v24, v24, v14, v36
    v_fma_f32 v25, v25, v14, v37
    v_fma_f32 v26, v26, v14, v38
    v_fma_f32 v27, v27, v14, v39
    v_cvt_pk_bf16_f32 v24, v24, v24
    v_cvt_pk_bf16_f32 v25, v25, v25
    v_cvt_pk_bf16_f32 v26, v26, v26
    v_cvt_pk_bf16_f32 v27, v27, v27
    buffer_store_short v24, v8, s[40:43], s44 offen offset:0
    buffer_store_short v25, v8, s[40:43], s44 offen offset:16
    buffer_store_short v26, v8, s[40:43], s44 offen offset:32
    buffer_store_short v27, v8, s[40:43], s44 offen offset:48
L_end:
    s_endpgm
.section .rodata,"a"
.p2align 6
.amdhsa_kernel standalone__gqa_softmax__sampling_kernel
  .amdhsa_next_free_vgpr 206
  .amdhsa_next_free_sgpr 64
  .amdhsa_accum_offset 208
  .amdhsa_group_segment_fixed_size 0
  .amdhsa_kernarg_size 48
  .amdhsa_user_sgpr_count 2
  .amdhsa_user_sgpr_kernarg_segment_ptr 1
  .amdhsa_system_sgpr_workgroup_id_x 1
.end_amdhsa_kernel
```
